```python
import torch

def _softmax(x, axis=-1):
    return torch.softmax(x, dim=axis)

def _gelu(x):
    return torch.nn.functional.gelu(x, approximate='tanh')

def _silu(x):
    return torch.nn.functional.silu(x)

def _sigmoid(x):
    return torch.sigmoid(x)

def _layernorm(x, axis=-1, eps=1e-05):
    m = x.mean(dim=axis, keepdim=True)
    v = x.var(dim=axis, keepdim=True, unbiased=False)
    return (x - m) / torch.sqrt(v + eps)

def _scatter_add(tgt, idx, src, axis=0):
    return tgt.clone().index_add_(axis, idx, src)

def _segment_sum(src, seg, n):
    out = torch.zeros((n,) + src.shape[1:], dtype=src.dtype)
    return out.index_add_(0, seg, src)

def _pad(x, pw):
    flat = tuple((v for pair in reversed(pw) for v in pair))
    return torch.nn.functional.pad(x, flat)
kernel_name = 'standalone__tree_speculative_verify_tree_attention_over_candidate_token_tree__decode'

def setup_inputs():

    _w = lambda a: (lambda t: t.to(torch.bfloat16) if t.is_floating_point() else t)(torch.as_tensor(a))
    B, Hq, Hkv, T, C, D = (2, 32, 8, 1, 8192, 128)
    tree_mask = torch.zeros((B, T, T), dtype=float)
    for b in range(B):
        parent = torch.zeros(T, dtype=torch.int64)
        for i in range(1, T):
            parent[i] = int(torch.randint(0, i, (1,)).item())
        for i in range(T):
            j = i
            tree_mask[b, i, j] = 1.0
            while j > 0:
                j = parent[j]
                tree_mask[b, i, j] = 1.0
    return {'q': _w((lambda *s: torch.randn(*s, dtype=torch.bfloat16) * 0.8)(B, Hq, T, D)), 'k_cache': _w((lambda *s: torch.randn(*s, dtype=torch.bfloat16) * 0.8)(B, Hkv, C, D)), 'v_cache': _w((lambda *s: torch.randn(*s, dtype=torch.bfloat16) * 0.05)(B, Hkv, C, D)), 'k_tree': _w((lambda *s: torch.randn(*s, dtype=torch.bfloat16) * 0.8)(B, Hkv, T, D)), 'v_tree': _w((lambda *s: torch.randn(*s, dtype=torch.bfloat16) * 0.05)(B, Hkv, T, D)), 'tree_mask': _w(tree_mask)}

def reference(q, k_cache, v_cache, k_tree, v_tree, tree_mask):
    B, Hq, T, D = q.shape
    Hkv, C = (k_cache.shape[1], k_cache.shape[2])
    rep = Hq // Hkv
    kc = (lambda x, n, axis: torch.repeat_interleave(x, n, dim=axis))(k_cache, rep, axis=1)
    vc = (lambda x, n, axis: torch.repeat_interleave(x, n, dim=axis))(v_cache, rep, axis=1)
    kt = (lambda x, n, axis: torch.repeat_interleave(x, n, dim=axis))(k_tree, rep, axis=1)
    vt = (lambda x, n, axis: torch.repeat_interleave(x, n, dim=axis))(v_tree, rep, axis=1)
    k = torch.concatenate([kc, kt], axis=2)
    v = torch.concatenate([vc, vt], axis=2)
    scale = D ** (-0.5)
    scores = torch.einsum('bhqd,bhkd->bhqk', q, k) * scale
    ctx_mask = torch.ones((B, 1, T, C), dtype=scores.dtype)
    tm = tree_mask[:, None, :, :].clone()
    full_mask = torch.concatenate([ctx_mask, tm], axis=-1)
    scores = scores + (1.0 - full_mask) * -1000000000.0
    p = _softmax(scores, axis=-1)
    return torch.einsum('bhqk,bhkd->bhqd', p, v)
```

```asm
; @launch grid=(256,1,1) block=(512,1,1) lds=136704
.amdgcn_target "amdgcn-amd-amdhsa--gfx950"
.text
.globl standalone__tree_speculative_verify_tree_attention_over_candidate_token_tree__decode_kernel
.p2align 8
.type standalone__tree_speculative_verify_tree_attention_over_candidate_token_tree__decode_kernel,@function
standalone__tree_speculative_verify_tree_attention_over_candidate_token_tree__decode_kernel:
    s_load_dwordx16 s[4:19], s[0:1], 0
    s_cmp_ge_u32 s2, 256
    s_cbranch_scc1 L_end
    v_and_b32 v1, 63, v0
    v_lshrrev_b32 v2, 6, v0
    v_and_b32 v3, 15, v0
    v_bfe_u32 v4, v0, 4, 2
    v_readfirstlane_b32 s3, v2
    s_and_b32 s22, s2, 15
    s_lshr_b32 s23, s2, 4
    s_lshl_b32 s51, s22, 4
    s_add_u32 s51, s51, s23
    s_lshl_b32 s54, s51, 17
    v_lshlrev_b32 v232, 10, v2
    v_lshlrev_b32 v234, 2, v4
    v_xor_b32 v234, v3, v234
    v_lshl_add_u32 v235, v4, 8, v232
    v_xor_b32 v76, 0, v234
    v_lshl_add_u32 v76, v76, 4, v235
    v_xor_b32 v77, 1, v234
    v_lshl_add_u32 v77, v77, 4, v235
    v_add_u32 v77, 7168, v77
    v_xor_b32 v78, 2, v234
    v_lshl_add_u32 v78, v78, 4, v235
    v_add_u32 v78, 14336, v78
    v_xor_b32 v79, 3, v234
    v_lshl_add_u32 v79, v79, 4, v235
    v_add_u32 v79, 21504, v79
    s_mov_b32 s44, 0x8000
    s_mov_b32 s45, 0x10000
    s_mov_b32 s46, 0x18000
    v_lshlrev_b32 v7, 4, v1
    s_mov_b32 s26, 0x20000
    s_mov_b32 s27, 0x00020000
    s_mov_b32 s30, 0x20000
    s_mov_b32 s31, 0x00020000
    s_mov_b32 s34, 0x200000
    s_mov_b32 s35, 0x00020000
    s_mov_b32 s86, 0x400
    s_mov_b32 s87, 0x00020000
    s_lshl_b32 s52, s22, 10
    s_lshl_b32 s53, s22, 8
    s_lshl_b32 s55, s3, 14
    s_add_u32 s55, s55, 5632
    s_waitcnt lgkmcnt(0)
    s_load_dwordx2 s[20:21], s[0:1], 64
    s_add_u32 s24, s6, s54
    s_addc_u32 s25, s7, 0
    s_and_b32 s25, s25, 0xffff
    s_add_u32 s84, s4, s52
    s_addc_u32 s85, s5, 0
    s_and_b32 s85, s85, 0xffff
    s_add_u32 s28, s8, s54
    s_addc_u32 s29, s9, 0
    s_and_b32 s29, s29, 0xffff
    s_cmp_eq_u32 s3, 0
    s_cbranch_scc0 L_nosw
    s_load_dword s88, s[84:85], 0
    s_load_dword s88, s[28:29], 0
    s_load_dword s88, s[12:13], 0
    s_load_dword s88, s[16:17], 0
    s_load_dword s88, s[10:11], 0
L_nosw:
    s_add_u32 m0, s55, 0
    s_nop 0
    buffer_load_dwordx4 v76, s[24:27], 0 offen offset:0 nt lds
    buffer_load_dwordx4 v77, s[24:27], 0 offen offset:1024 nt lds
    buffer_load_dwordx4 v78, s[24:27], 0 offen offset:2048 nt lds
    buffer_load_dwordx4 v79, s[24:27], 0 offen offset:3072 nt lds
    s_add_u32 m0, s55, 4096
    s_nop 0
    buffer_load_dwordx4 v76, s[24:27], s44 offen offset:0 nt lds
    buffer_load_dwordx4 v77, s[24:27], s44 offen offset:1024 nt lds
    buffer_load_dwordx4 v78, s[24:27], s44 offen offset:2048 nt lds
    buffer_load_dwordx4 v79, s[24:27], s44 offen offset:3072 nt lds
    s_add_u32 m0, s55, 8192
    s_nop 0
    buffer_load_dwordx4 v76, s[24:27], s45 offen offset:0 nt lds
    buffer_load_dwordx4 v77, s[24:27], s45 offen offset:1024 nt lds
    buffer_load_dwordx4 v78, s[24:27], s45 offen offset:2048 nt lds
    buffer_load_dwordx4 v79, s[24:27], s45 offen offset:3072 nt lds
    s_add_u32 m0, s55, 12288
    s_nop 0
    buffer_load_dwordx4 v76, s[24:27], s46 offen offset:0 nt lds
    buffer_load_dwordx4 v77, s[24:27], s46 offen offset:1024 nt lds
    buffer_load_dwordx4 v78, s[24:27], s46 offen offset:2048 nt lds
    buffer_load_dwordx4 v79, s[24:27], s46 offen offset:3072 nt lds
    s_mov_b32 m0, 512
    s_nop 0
    buffer_load_dwordx4 v7, s[84:87], 0 offen lds
    s_or_b32 s56, s3, s23
    s_cmp_eq_u32 s56, 0
    s_cbranch_scc0 L_nokt
    v_lshlrev_b32 v8, 4, v4
    v_add_u32 v8, s53, v8
    global_load_dwordx4 v[28:31], v8, s[10:11] offset:0
    global_load_dwordx4 v[32:35], v8, s[10:11] offset:64
    global_load_dwordx4 v[36:39], v8, s[10:11] offset:128
    global_load_dwordx4 v[40:43], v8, s[10:11] offset:192
    s_load_dword s62, s[14:15], 0
L_nokt:
    s_waitcnt lgkmcnt(0)
    s_mov_b32 s32, s20
    s_and_b32 s33, s21, 0xffff
    s_cmp_eq_u32 s3, 0
    s_cbranch_scc0 L_nosw2
    s_load_dword s88, s[20:21], 0
L_nosw2:
    s_barrier
    s_lshl_b32 s58, s22, 7
    s_add_u32 s60, s58, 0xb0000
    buffer_load_dword v251, off, s[32:35], s60 sc1
    s_lshl_b32 s58, s51, 6
    s_add_u32 s58, s58, 0xa0000
    buffer_load_dword v247, off, s[32:35], s58 sc1
    v_lshlrev_b32 v9, 1, v3
    v_lshl_add_u32 v9, v2, 5, v9
    v_add_u32 v9, s53, v9
    global_load_ushort v9, v9, s[12:13]
    v_lshlrev_b32 v10, 8, v2
    v_lshl_add_u32 v10, v1, 2, v10
    v_and_b32 v240, 1, v4
    v_lshlrev_b32 v241, 1, v240
    v_lshrrev_b32 v242, 1, v4
    v_or_b32 v250, v241, v242
    v_and_b32 v241, 1, v2
    v_lshlrev_b32 v241, 2, v241
    v_lshl_add_u32 v241, v240, 3, v241
    v_xor_b32 v241, v3, v241
    v_lshlrev_b32 v242, 10, v2
    v_lshl_add_u32 v242, v4, 8, v242
    v_lshl_add_u32 v84, v241, 4, v242
    v_xor_b32 v241, 2, v241
    v_lshl_add_u32 v85, v241, 4, v242
    v_lshrrev_b32 v241, 2, v3
    v_lshlrev_b32 v242, 1, v241
    v_lshl_add_u32 v242, v240, 3, v242
    v_bfe_u32 v243, v3, 1, 1
    v_lshl_add_u32 v243, v2, 1, v243
    v_xor_b32 v242, v242, v243
    v_lshlrev_b32 v86, 4, v242
    v_and_b32 v243, 1, v3
    v_lshl_add_u32 v86, v243, 3, v86
    v_lshl_add_u32 v86, v4, 8, v86
    v_and_b32 v243, 1, v241
    v_lshl_add_u32 v86, v243, 10, v86
    v_lshrrev_b32 v243, 1, v241
    v_lshl_add_u32 v86, v243, 14, v86
    v_add_u32 v87, 0x10000, v86
    v_lshlrev_b32 v89, 6, v4
    v_lshl_add_u32 v88, v3, 4, v89
    v_lshl_add_u32 v89, v241, 4, v89
    s_lshr_b32 s36, s3, 2
    s_lshl_b32 s36, s36, 8
    s_and_b32 s37, s3, 3
    s_lshl_b32 s37, s37, 2
    s_add_u32 s36, s36, s37
    v_add_u32 v88, s36, v88
    v_lshrrev_b32 v240, 3, v1
    v_and_b32 v241, 7, v1
    s_mul_i32 s36, s22, 32768
    s_lshl_b32 s37, s23, 7
    s_add_u32 s36, s36, s37
    v_mul_u32_u24 v11, 2048, v240
    v_lshl_add_u32 v11, v241, 4, v11
    v_add_u32 v11, s36, v11
    v_lshrrev_b32 v246, 2, v241
    s_and_b32 s37, s23, 1
    s_lshl_b32 s37, s37, 1
    v_add_u32 v246, s37, v246
    v_lshlrev_b32 v5, 6, v240
    v_lshl_add_u32 v5, v246, 4, v5
    s_lshl_b32 s37, s22, 10
    s_add_u32 s37, s37, 0xa0000
    v_add_u32 v5, s37, v5
    v_and_b32 v241, 3, v241
    v_lshl_add_u32 v241, v241, 2, v250
    v_lshlrev_b32 v241, 1, v241
    v_lshl_add_u32 v245, v246, 8, v241
    s_lshr_b32 s37, s23, 1
    s_lshl_b32 s37, s37, 5
    s_add_u32 s37, s37, s52
    v_add_u32 v245, s37, v245
    s_mov_b32 s38, 16384
    v_and_b32 v233, 3, v3
    v_lshlrev_b32 v235, 14, v2
    v_lshl_add_u32 v235, v233, 10, v235
    v_lshrrev_b32 v234, 2, v3
    v_lshl_add_u32 v235, v234, 8, v235
    v_xor_b32 v234, v4, v3
    v_xor_b32 v80, 0, v234
    v_lshl_add_u32 v80, v80, 4, v235
    v_xor_b32 v81, 4, v234
    v_lshl_add_u32 v81, v81, 4, v235
    v_xor_b32 v82, 8, v234
    v_lshl_add_u32 v82, v82, 4, v235
    v_xor_b32 v83, 12, v234
    v_lshl_add_u32 v83, v83, 4, v235
    v_lshlrev_b32 v7, 8, v233
    v_lshl_add_u32 v7, v4, 4, v7
    s_waitcnt vmcnt(3)
    ds_read_b128 v[12:15], v7 offset:512
    ds_read_b128 v[16:19], v7 offset:576
    ds_read_b128 v[20:23], v7 offset:640
    ds_read_b128 v[24:27], v7 offset:704
    ds_read_b128 v[44:47], v80 offset:5632
    ds_read_b128 v[48:51], v81 offset:5632
    ds_read_b128 v[52:55], v82 offset:5632
    ds_read_b128 v[56:59], v83 offset:5632
    s_waitcnt lgkmcnt(3)
    v_mfma_f32_16x16x32_bf16 v[92:95], v[44:47], v[12:15], 0
    s_waitcnt lgkmcnt(2)
    v_mfma_f32_16x16x32_bf16 v[92:95], v[48:51], v[16:19], v[92:95]
    s_waitcnt lgkmcnt(1)
    v_mfma_f32_16x16x32_bf16 v[92:95], v[52:55], v[20:23], v[92:95]
    s_waitcnt lgkmcnt(0)
    v_mfma_f32_16x16x32_bf16 v[92:95], v[56:59], v[24:27], v[92:95]
    s_waitcnt vmcnt(3)
    ds_read_b128 v[60:63], v80 offset:9728
    ds_read_b128 v[64:67], v81 offset:9728
    ds_read_b128 v[68:71], v82 offset:9728
    ds_read_b128 v[72:75], v83 offset:9728
    s_waitcnt lgkmcnt(3)
    v_mfma_f32_16x16x32_bf16 v[96:99], v[60:63], v[12:15], 0
    s_waitcnt lgkmcnt(2)
    v_mfma_f32_16x16x32_bf16 v[96:99], v[64:67], v[16:19], v[96:99]
    s_waitcnt lgkmcnt(1)
    v_mfma_f32_16x16x32_bf16 v[96:99], v[68:71], v[20:23], v[96:99]
    s_waitcnt lgkmcnt(0)
    v_mfma_f32_16x16x32_bf16 v[96:99], v[72:75], v[24:27], v[96:99]
    s_waitcnt vmcnt(3)
    ds_read_b128 v[44:47], v80 offset:13824
    ds_read_b128 v[48:51], v81 offset:13824
    ds_read_b128 v[52:55], v82 offset:13824
    ds_read_b128 v[56:59], v83 offset:13824
    s_waitcnt lgkmcnt(3)
    v_mfma_f32_16x16x32_bf16 v[100:103], v[44:47], v[12:15], 0
    s_waitcnt lgkmcnt(2)
    v_mfma_f32_16x16x32_bf16 v[100:103], v[48:51], v[16:19], v[100:103]
    s_waitcnt lgkmcnt(1)
    v_mfma_f32_16x16x32_bf16 v[100:103], v[52:55], v[20:23], v[100:103]
    s_waitcnt lgkmcnt(0)
    v_mfma_f32_16x16x32_bf16 v[100:103], v[56:59], v[24:27], v[100:103]
    s_waitcnt vmcnt(3)
    ds_read_b128 v[60:63], v80 offset:17920
    ds_read_b128 v[64:67], v81 offset:17920
    ds_read_b128 v[68:71], v82 offset:17920
    ds_read_b128 v[72:75], v83 offset:17920
    s_waitcnt lgkmcnt(3)
    v_mfma_f32_16x16x32_bf16 v[104:107], v[60:63], v[12:15], 0
    s_waitcnt lgkmcnt(2)
    v_mfma_f32_16x16x32_bf16 v[104:107], v[64:67], v[16:19], v[104:107]
    s_waitcnt lgkmcnt(1)
    v_mfma_f32_16x16x32_bf16 v[104:107], v[68:71], v[20:23], v[104:107]
    s_waitcnt lgkmcnt(0)
    v_mfma_f32_16x16x32_bf16 v[104:107], v[72:75], v[24:27], v[104:107]
    s_add_u32 m0, s55, 0
    s_mov_b32 s58, 0x0
    buffer_load_dwordx4 v84, s[28:31], s58 offen nt lds
    s_add_u32 m0, m0, 1024
    s_add_u32 s58, s58, 0x2000
    buffer_load_dwordx4 v85, s[28:31], s58 offen nt lds
    s_add_u32 m0, m0, 1024
    s_add_u32 s58, s58, 0x2000
    buffer_load_dwordx4 v84, s[28:31], s58 offen nt lds
    s_add_u32 m0, m0, 1024
    s_add_u32 s58, s58, 0x2000
    buffer_load_dwordx4 v85, s[28:31], s58 offen nt lds
    s_add_u32 m0, m0, 1024
    s_add_u32 s58, s58, 0x2000
    buffer_load_dwordx4 v84, s[28:31], s58 offen nt lds
    s_add_u32 m0, m0, 1024
    s_add_u32 s58, s58, 0x2000
    buffer_load_dwordx4 v85, s[28:31], s58 offen nt lds
    s_add_u32 m0, m0, 1024
    s_add_u32 s58, s58, 0x2000
    buffer_load_dwordx4 v84, s[28:31], s58 offen nt lds
    s_add_u32 m0, m0, 1024
    s_add_u32 s58, s58, 0x2000
    buffer_load_dwordx4 v85, s[28:31], s58 offen nt lds
    s_cmp_eq_u32 s3, 0
    s_cbranch_scc0 L_notree
    v_mov_b32 v240, 0xff61b1e6
    s_cmp_eq_u32 s23, 0
    s_cbranch_scc0 L_tree1
    s_waitcnt vmcnt(8)
    v_mfma_f32_16x16x32_bf16 v[108:111], v[28:31], v[12:15], 0
    v_mfma_f32_16x16x32_bf16 v[108:111], v[32:35], v[16:19], v[108:111]
    v_mfma_f32_16x16x32_bf16 v[108:111], v[36:39], v[20:23], v[108:111]
    v_mfma_f32_16x16x32_bf16 v[108:111], v[40:43], v[24:27], v[108:111]
    s_waitcnt lgkmcnt(0)
    s_lshr_b32 s58, s22, 3
    s_lshl_b32 s58, s58, 4
    s_lshr_b32 s58, s62, s58
    s_lshl_b32 s58, s58, 16
    v_mov_b32 v240, s58
    v_sub_f32 v240, 1.0, v240
    s_mov_b32 s58, 0xd028965f
    s_nop 3
    v_fma_f32 v240, v240, s58, v108
L_tree1:
    v_lshlrev_b32 v241, 2, v3
    s_mov_b64 exec, 0xf
    ds_write_b32 v241, v240 offset:256
    s_mov_b64 exec, -1
L_notree:
    v_max3_f32 v232, v92, v93, v94
    v_max3_f32 v233, v95, v96, v97
    v_max3_f32 v234, v98, v99, v100
    v_max3_f32 v235, v101, v102, v103
    s_nop 4
    v_max3_f32 v232, v232, v104, v105
    v_max3_f32 v233, v233, v106, v107
    v_max3_f32 v232, v232, v233, v234
    v_max_f32 v232, v232, v235
    v_mov_b32 v233, v232
    s_nop 1
    v_permlane32_swap_b32 v232, v233
    v_max_f32 v232, v232, v233
    v_mov_b32 v233, v232
    s_nop 1
    v_permlane16_swap_b32 v232, v233
    v_max_f32 v232, v232, v233
    v_and_b32 v242, 3, v3
    v_lshlrev_b32 v234, 5, v242
    s_lshl_b32 s58, s3, 2
    v_add_u32 v235, s58, v234
    v_lshlrev_b32 v242, 2, v242
    s_mov_b64 exec, 0xf
    ds_write_b32 v235, v232 offset:0
    s_mov_b64 exec, -1
    s_waitcnt lgkmcnt(0)
    s_barrier
    s_mul_i32 s57, s51, 2048
    buffer_load_dword v247, v10, s[32:35], s57 offen sc1
    s_add_u32 m0, s55, 8192
    s_mov_b32 s58, 0x10000
    buffer_load_dwordx4 v84, s[28:31], s58 offen nt lds
    s_add_u32 m0, m0, 1024
    s_add_u32 s58, s58, 0x2000
    buffer_load_dwordx4 v85, s[28:31], s58 offen nt lds
    s_add_u32 m0, m0, 1024
    s_add_u32 s58, s58, 0x2000
    buffer_load_dwordx4 v84, s[28:31], s58 offen nt lds
    s_add_u32 m0, m0, 1024
    s_add_u32 s58, s58, 0x2000
    buffer_load_dwordx4 v85, s[28:31], s58 offen nt lds
    ds_read_b128 v[236:239], v234 offset:0
    ds_read_b128 v[44:47], v234 offset:16
    ds_read_b32 v240, v242 offset:256
    s_mov_b32 s63, 0x3e0293ee
    s_waitcnt vmcnt(13)
    v_add_u32 v251, 1, v251
    s_nop 0
    v_readfirstlane_b32 s39, v251
    s_nop 1
    s_and_b32 s47, s39, 0xff
    s_mul_i32 s47, s47, 0x01010100
    s_and_b32 s48, s39, 0x7f7f7f7f
    s_and_b32 s49, s47, 0x7f7f7f7f
    s_add_u32 s48, s48, s49
    s_xor_b32 s47, s47, s39
    s_and_b32 s47, s47, 0x80808080
    s_xor_b32 s50, s48, s47
    v_and_b32 v243, 3, v3
    v_lshlrev_b32 v243, 3, v243
    v_lshrrev_b32 v248, v243, s50
    v_and_b32 v248, 0xff, v248
    v_xor_b32 v243, 0xff, v248
    v_lshlrev_b32 v241, 2, v1
    ds_write_b32 v241, v243 offset:512
    s_waitcnt lgkmcnt(0)
    v_max3_f32 v232, v236, v237, v238
    v_max3_f32 v233, v239, v44, v45
    v_max3_f32 v232, v232, v46, v47
    v_max3_f32 v232, v232, v233, v240
    v_sub_f32 v92, v92, v232
    v_sub_f32 v93, v93, v232
    v_sub_f32 v94, v94, v232
    v_sub_f32 v95, v95, v232
    v_sub_f32 v96, v96, v232
    v_sub_f32 v97, v97, v232
    v_sub_f32 v98, v98, v232
    v_sub_f32 v99, v99, v232
    v_sub_f32 v100, v100, v232
    v_sub_f32 v101, v101, v232
    v_sub_f32 v102, v102, v232
    v_sub_f32 v103, v103, v232
    v_sub_f32 v104, v104, v232
    v_sub_f32 v105, v105, v232
    v_sub_f32 v106, v106, v232
    v_sub_f32 v107, v107, v232
    v_sub_f32 v240, v240, v232
    v_mul_f32 v92, s63, v92
    v_mul_f32 v93, s63, v93
    v_mul_f32 v94, s63, v94
    v_mul_f32 v95, s63, v95
    v_mul_f32 v96, s63, v96
    v_mul_f32 v97, s63, v97
    v_mul_f32 v98, s63, v98
    v_mul_f32 v99, s63, v99
    v_mul_f32 v100, s63, v100
    v_mul_f32 v101, s63, v101
    v_mul_f32 v102, s63, v102
    v_mul_f32 v103, s63, v103
    v_mul_f32 v104, s63, v104
    v_mul_f32 v105, s63, v105
    v_mul_f32 v106, s63, v106
    v_mul_f32 v107, s63, v107
    v_mul_f32 v240, s63, v240
    v_exp_f32 v92, v92
    v_exp_f32 v93, v93
    v_exp_f32 v94, v94
    v_exp_f32 v95, v95
    v_exp_f32 v96, v96
    v_exp_f32 v97, v97
    v_exp_f32 v98, v98
    v_exp_f32 v99, v99
    v_exp_f32 v100, v100
    v_exp_f32 v101, v101
    v_exp_f32 v102, v102
    v_exp_f32 v103, v103
    v_exp_f32 v104, v104
    v_exp_f32 v105, v105
    v_exp_f32 v106, v106
    v_exp_f32 v107, v107
    v_exp_f32 v240, v240
    v_mul_f32 v232, s63, v232
    v_add_f32 v233, v92, v93
    v_add_f32 v236, v94, v95
    v_add_f32 v233, v233, v96
    v_add_f32 v236, v236, v97
    v_add_f32 v233, v233, v98
    v_add_f32 v236, v236, v99
    v_add_f32 v233, v233, v100
    v_add_f32 v236, v236, v101
    v_add_f32 v233, v233, v102
    v_add_f32 v236, v236, v103
    v_add_f32 v233, v233, v104
    v_add_f32 v236, v236, v105
    v_add_f32 v233, v233, v106
    v_add_f32 v236, v236, v107
    v_add_f32 v233, v233, v236
    v_cvt_pk_bf16_f32 v28, v92, v93
    v_cvt_pk_bf16_f32 v29, v94, v95
    v_cvt_pk_bf16_f32 v30, v96, v97
    v_cvt_pk_bf16_f32 v31, v98, v99
    v_cvt_pk_bf16_f32 v32, v100, v101
    v_cvt_pk_bf16_f32 v33, v102, v103
    v_cvt_pk_bf16_f32 v34, v104, v105
    v_cvt_pk_bf16_f32 v35, v106, v107
    v_mov_b32 v236, v233
    s_nop 1
    v_permlane32_swap_b32 v233, v236
    v_add_f32 v233, v233, v236
    v_mov_b32 v236, v233
    s_nop 1
    v_permlane16_swap_b32 v233, v236
    v_add_f32 v233, v233, v236
    s_mov_b64 exec, 0xf
    ds_write_b32 v235, v233 offset:128
    s_cmp_eq_u32 s3, 0
    s_cbranch_scc0 L_nomq
    ds_write_b32 v242, v240 offset:288
L_nomq:
    s_mov_b64 exec, -1
    s_mov_b32 exec_lo, 0x000f000f
    s_mov_b32 exec_hi, 0x000f000f
    ds_write_b32 v88, v28 offset:1536
    ds_write_b32 v88, v29 offset:2048
    ds_write_b32 v88, v30 offset:2560
    ds_write_b32 v88, v31 offset:3072
    ds_write_b32 v88, v32 offset:3584
    ds_write_b32 v88, v33 offset:4096
    ds_write_b32 v88, v34 offset:4608
    ds_write_b32 v88, v35 offset:5120
    s_mov_b64 exec, -1
    s_waitcnt lgkmcnt(0)
    s_barrier
    v_lshlrev_b32 v241, 2, v4
    ds_read_b32 v244, v241 offset:288
    s_cmp_eq_u32 s3, 0
    s_cbranch_scc0 L_noml
    ds_read_b128 v[44:47], v234 offset:128
    ds_read_b128 v[48:51], v234 offset:144
    s_lshl_b32 s61, s51, 6
    s_add_u32 s61, s61, 0xa0000
    s_add_u32 s56, s61, 0x100000
    v_lshlrev_b32 v56, 4, v3
    s_waitcnt lgkmcnt(0)
    v_add_f32 v44, v44, v45
    v_add_f32 v46, v46, v47
    v_add_f32 v48, v48, v49
    v_add_f32 v50, v50, v51
    v_add_f32 v44, v44, v46
    v_add_f32 v48, v48, v50
    v_add_f32 v44, v44, v48
    v_mov_b32 v52, v232
    v_add_f32 v53, v44, v240
    v_mov_b32 v54, v251
    v_mov_b32 v55, v251
    s_mov_b64 exec, 0xf
    buffer_store_dwordx4 v[52:55], v56, s[32:35], s61 offen
    buffer_store_dwordx4 v[52:55], v56, s[32:35], s56 offen sc1
    s_mov_b64 exec, -1
L_noml:
    s_add_u32 m0, s55, 12288
    s_mov_b32 s58, 0x18000
    buffer_load_dwordx4 v84, s[28:31], s58 offen nt lds
    s_add_u32 m0, m0, 1024
    s_add_u32 s58, s58, 0x2000
    buffer_load_dwordx4 v85, s[28:31], s58 offen nt lds
    s_add_u32 m0, m0, 1024
    s_add_u32 s58, s58, 0x2000
    buffer_load_dwordx4 v84, s[28:31], s58 offen nt lds
    s_add_u32 m0, m0, 1024
    s_add_u32 s58, s58, 0x2000
    buffer_load_dwordx4 v85, s[28:31], s58 offen nt lds
    ds_read_b128 v[112:115], v89 offset:1536
    ds_read_b128 v[116:119], v89 offset:1792
    ds_read_b128 v[120:123], v89 offset:2048
    ds_read_b128 v[124:127], v89 offset:2304
    ds_read_b128 v[128:131], v89 offset:2560
    ds_read_b128 v[132:135], v89 offset:2816
    ds_read_b128 v[136:139], v89 offset:3072
    ds_read_b128 v[140:143], v89 offset:3328
    ds_read_b128 v[144:147], v89 offset:3584
    ds_read_b128 v[148:151], v89 offset:3840
    s_waitcnt lgkmcnt(4)
    ds_read_b128 v[152:155], v89 offset:4096
    ds_read_b128 v[156:159], v89 offset:4352
    ds_read_b128 v[160:163], v89 offset:4608
    ds_read_b128 v[164:167], v89 offset:4864
    ds_read_b128 v[168:171], v89 offset:5120
    ds_read_b128 v[172:175], v89 offset:5376
    s_waitcnt vmcnt(9) lgkmcnt(0)
    s_barrier
    ds_read_b64_tr_b16 v[176:177], v86 offset:5632
    ds_read_b64_tr_b16 v[178:179], v86 offset:38400
    ds_read_b64_tr_b16 v[180:181], v87 offset:5632
    ds_read_b64_tr_b16 v[182:183], v87 offset:38400
    ds_read_b64_tr_b16 v[184:185], v86 offset:7680
    ds_read_b64_tr_b16 v[186:187], v86 offset:40448
    ds_read_b64_tr_b16 v[188:189], v87 offset:7680
    ds_read_b64_tr_b16 v[190:191], v87 offset:40448
    s_waitcnt lgkmcnt(6)
    v_mfma_f32_16x16x32_bf16 v[208:211], v[112:115], v[176:179], 0
    s_waitcnt lgkmcnt(4)
    v_mfma_f32_16x16x32_bf16 v[212:215], v[116:119], v[180:183], 0
    s_waitcnt lgkmcnt(2)
    v_mfma_f32_16x16x32_bf16 v[208:211], v[120:123], v[184:187], v[208:211]
    s_waitcnt lgkmcnt(0)
    v_mfma_f32_16x16x32_bf16 v[212:215], v[124:127], v[188:191], v[212:215]
    ds_read_b64_tr_b16 v[192:193], v86 offset:9728
    ds_read_b64_tr_b16 v[194:195], v86 offset:42496
    ds_read_b64_tr_b16 v[196:197], v87 offset:9728
    ds_read_b64_tr_b16 v[198:199], v87 offset:42496
    ds_read_b64_tr_b16 v[200:201], v86 offset:11776
    ds_read_b64_tr_b16 v[202:203], v86 offset:44544
    ds_read_b64_tr_b16 v[204:205], v87 offset:11776
    ds_read_b64_tr_b16 v[206:207], v87 offset:44544
    s_waitcnt lgkmcnt(6)
    v_mfma_f32_16x16x32_bf16 v[208:211], v[128:131], v[192:195], v[208:211]
    s_waitcnt lgkmcnt(4)
    v_mfma_f32_16x16x32_bf16 v[212:215], v[132:135], v[196:199], v[212:215]
    s_waitcnt lgkmcnt(2)
    v_mfma_f32_16x16x32_bf16 v[208:211], v[136:139], v[200:203], v[208:211]
    s_waitcnt lgkmcnt(0)
    v_mfma_f32_16x16x32_bf16 v[212:215], v[140:143], v[204:207], v[212:215]
    s_waitcnt vmcnt(4)
    v_lshlrev_b32 v9, 16, v9
    v_mul_f32 v244, v244, v9
    s_barrier
    ds_read_b64_tr_b16 v[176:177], v86 offset:13824
    ds_read_b64_tr_b16 v[178:179], v86 offset:46592
    ds_read_b64_tr_b16 v[180:181], v87 offset:13824
    ds_read_b64_tr_b16 v[182:183], v87 offset:46592
    ds_read_b64_tr_b16 v[184:185], v86 offset:15872
    ds_read_b64_tr_b16 v[186:187], v86 offset:48640
    ds_read_b64_tr_b16 v[188:189], v87 offset:15872
    ds_read_b64_tr_b16 v[190:191], v87 offset:48640
    s_waitcnt lgkmcnt(6)
    v_mfma_f32_16x16x32_bf16 v[208:211], v[144:147], v[176:179], v[208:211]
    s_waitcnt lgkmcnt(4)
    v_mfma_f32_16x16x32_bf16 v[212:215], v[148:151], v[180:183], v[212:215]
    s_waitcnt lgkmcnt(2)
    v_mfma_f32_16x16x32_bf16 v[208:211], v[152:155], v[184:187], v[208:211]
    s_waitcnt lgkmcnt(0)
    v_mfma_f32_16x16x32_bf16 v[212:215], v[156:159], v[188:191], v[212:215]
    s_waitcnt vmcnt(2)
    s_barrier
    ds_read_b64_tr_b16 v[176:177], v86 offset:17920
    ds_read_b64_tr_b16 v[178:179], v86 offset:50688
    ds_read_b64_tr_b16 v[180:181], v87 offset:17920
    ds_read_b64_tr_b16 v[182:183], v87 offset:50688
    s_waitcnt lgkmcnt(2)
    v_mfma_f32_16x16x32_bf16 v[208:211], v[160:163], v[176:179], v[208:211]
    s_waitcnt lgkmcnt(0)
    v_mfma_f32_16x16x32_bf16 v[212:215], v[164:167], v[180:183], v[212:215]
    s_add_u32 s59, s57, 0x100000
    s_mov_b32 s58, 0xffffff00
    s_waitcnt vmcnt(0)
    s_cmp_eq_u32 s3, 1
    s_cbranch_scc0 L_nomlphase
    buffer_load_dwordx4 v[60:63], v5, s[32:35], 0 offen sc1
    buffer_load_dwordx4 v[64:67], v5, s[32:35], 0 offen offset:512 sc1
L_nomlphase:
    s_barrier
    ds_read_b64_tr_b16 v[176:177], v86 offset:19968
    ds_read_b64_tr_b16 v[178:179], v86 offset:52736
    ds_read_b64_tr_b16 v[180:181], v87 offset:19968
    ds_read_b64_tr_b16 v[182:183], v87 offset:52736
    s_waitcnt lgkmcnt(2)
    v_mfma_f32_16x16x32_bf16 v[208:211], v[168:171], v[176:179], v[208:211]
    s_waitcnt lgkmcnt(0)
    v_mfma_f32_16x16x32_bf16 v[212:215], v[172:175], v[180:183], v[212:215]
    v_lshlrev_b32 v46, 2, v1
    s_nop 6
    v_add_f32 v44, v208, v212
    v_add_f32 v44, v44, v244
    v_and_or_b32 v45, v44, s58, v248
    buffer_store_dword v45, v10, s[32:35], s57 offen
    s_cmp_eq_u32 s3, 1
    s_cbranch_scc1 L_final
    buffer_store_dword v45, v10, s[32:35], s59 offen sc1
    s_cmp_eq_u32 s3, 0
    s_cbranch_scc0 L_pubdone
    s_mov_b32 s54, 0
L_bpoll:
    ds_read_b32 v47, v46 offset:512
    s_waitcnt lgkmcnt(0)
    v_xor_b32 v48, v47, v248
    v_and_b32 v48, 0xff, v48
    v_cmp_ne_u32 vcc, 0, v48
    s_cbranch_vccz L_bgo
    s_add_u32 s54, s54, 1
    s_cmp_lt_u32 s54, 0x400000
    s_cbranch_scc1 L_bpoll
L_bgo:
    v_add_u32 v49, 256, v10
    buffer_store_dword v47, v49, s[32:35], s59 offen sc1
L_pubdone:
    s_branch L_end
L_final:
    ds_write_b32 v46, v45 offset:512
    s_and_b32 s40, s50, 0xff
    s_bfe_u32 s41, s50, 0x80008
    s_bfe_u32 s42, s50, 0x80010
    s_lshr_b32 s43, s50, 24
    s_mov_b32 s54, 0
    buffer_load_dwordx4 v[112:115], v11, s[32:35], 0 offen sc1
    buffer_load_dwordx4 v[116:119], v11, s[32:35], s38 offen sc1
    s_waitcnt vmcnt(3)
    s_branch L_mlchk
L_mlpoll:
    buffer_load_dwordx4 v[60:63], v5, s[32:35], 0 offen sc1
    buffer_load_dwordx4 v[64:67], v5, s[32:35], 0 offen offset:512 sc1
    s_waitcnt vmcnt(0)
L_mlchk:
    v_xor_b32 v68, s39, v62
    v_bitop3_b32 v68, v66, s39, v68 bitop3:0xbe
    v_bitop3_b32 v68, v63, s39, v68 bitop3:0xbe
    v_bitop3_b32 v68, v67, s39, v68 bitop3:0xbe
    v_cmp_ne_u32 vcc, 0, v68
    s_cbranch_vccz L_mlok
    s_add_u32 s54, s54, 1
    s_cmp_lt_u32 s54, 0x40000
    s_cbranch_scc0 L_mlok
    s_cmp_lt_u32 s54, 24
    s_cbranch_scc1 L_mlpoll
    v_xor_b32 v5, 0x100000, v5
    s_branch L_mlpoll
L_mlok:
    v_max_f32 v70, v60, v64
    s_mov_b32 s54, 0
    s_nop 0
    v_max_f32_dpp v70, v70, v70 row_ror:8 row_mask:0xf bank_mask:0xf
    v_mov_b32 v71, v70
    s_nop 1
    v_permlane32_swap_b32 v70, v71
    v_max_f32 v70, v70, v71
    v_mov_b32 v71, v70
    s_nop 1
    v_permlane16_swap_b32 v70, v71
    v_max_f32 v70, v70, v71
    v_sub_f32 v71, v64, v70
    v_sub_f32 v70, v60, v70
    v_exp_f32 v71, v71
    v_exp_f32 v70, v70
    buffer_load_dwordx4 v[120:123], v11, s[32:35], 0 offen sc1
    buffer_load_dwordx4 v[124:127], v11, s[32:35], s38 offen sc1
    s_nop 0
    v_mul_f32 v72, v71, v65
    v_fmac_f32 v72, v70, v61
    s_nop 1
    v_add_f32_dpp v72, v72, v72 row_ror:8 row_mask:0xf bank_mask:0xf
    buffer_load_dwordx4 v[128:131], v11, s[32:35], 0 offen sc1
    buffer_load_dwordx4 v[132:135], v11, s[32:35], s38 offen sc1
    v_mov_b32 v73, v72
    s_nop 1
    v_permlane32_swap_b32 v72, v73
    v_add_f32 v72, v72, v73
    v_mov_b32 v73, v72
    s_nop 1
    v_permlane16_swap_b32 v72, v73
    v_add_f32 v72, v72, v73
    v_rcp_f32 v72, v72
L_owait:
    s_waitcnt vmcnt(4)
    v_xor_b32 v68, s40, v112
    v_xor_b32 v69, s41, v113
    v_bitop3_b32 v68, v114, s42, v68 bitop3:0xbe
    v_bitop3_b32 v69, v115, s43, v69 bitop3:0xbe
    v_bitop3_b32 v68, v116, s40, v68 bitop3:0xbe
    v_bitop3_b32 v69, v117, s41, v69 bitop3:0xbe
    v_bitop3_b32 v68, v118, s42, v68 bitop3:0xbe
    v_bitop3_b32 v69, v119, s43, v69 bitop3:0xbe
    v_or_b32 v68, v68, v69
    v_and_b32 v68, 0xff, v68
    v_cmp_ne_u32 vcc, 0, v68
    s_cbranch_vccz L_ok0
    buffer_load_dwordx4 v[112:115], v11, s[32:35], 0 offen sc1
    buffer_load_dwordx4 v[116:119], v11, s[32:35], s38 offen sc1
    s_waitcnt vmcnt(4)
    v_xor_b32 v68, s40, v120
    v_xor_b32 v69, s41, v121
    v_bitop3_b32 v68, v122, s42, v68 bitop3:0xbe
    v_bitop3_b32 v69, v123, s43, v69 bitop3:0xbe
    v_bitop3_b32 v68, v124, s40, v68 bitop3:0xbe
    v_bitop3_b32 v69, v125, s41, v69 bitop3:0xbe
    v_bitop3_b32 v68, v126, s42, v68 bitop3:0xbe
    v_bitop3_b32 v69, v127, s43, v69 bitop3:0xbe
    v_or_b32 v68, v68, v69
    v_and_b32 v68, 0xff, v68
    v_cmp_ne_u32 vcc, 0, v68
    s_cbranch_vccz L_ok1
    buffer_load_dwordx4 v[120:123], v11, s[32:35], 0 offen sc1
    buffer_load_dwordx4 v[124:127], v11, s[32:35], s38 offen sc1
    s_waitcnt vmcnt(4)
    v_xor_b32 v68, s40, v128
    v_xor_b32 v69, s41, v129
    v_bitop3_b32 v68, v130, s42, v68 bitop3:0xbe
    v_bitop3_b32 v69, v131, s43, v69 bitop3:0xbe
    v_bitop3_b32 v68, v132, s40, v68 bitop3:0xbe
    v_bitop3_b32 v69, v133, s41, v69 bitop3:0xbe
    v_bitop3_b32 v68, v134, s42, v68 bitop3:0xbe
    v_bitop3_b32 v69, v135, s43, v69 bitop3:0xbe
    v_or_b32 v68, v68, v69
    v_and_b32 v68, 0xff, v68
    v_cmp_ne_u32 vcc, 0, v68
    s_cbranch_vccz L_ok2
    s_add_u32 s54, s54, 1
    s_cmp_lt_u32 s54, 0x40000
    s_cbranch_scc0 L_ok2
    s_cmp_lt_u32 s54, 24
    s_cbranch_scc1 L_otog
    v_xor_b32 v11, 0x100000, v11
L_otog:
    buffer_load_dwordx4 v[128:131], v11, s[32:35], 0 offen sc1
    buffer_load_dwordx4 v[132:135], v11, s[32:35], s38 offen sc1
    s_branch L_owait
L_ok0:
    v_and_b32 v112, s58, v112
    v_and_b32 v113, s58, v113
    v_and_b32 v114, s58, v114
    v_and_b32 v115, s58, v115
    v_and_b32 v116, s58, v116
    v_and_b32 v117, s58, v117
    v_and_b32 v118, s58, v118
    v_and_b32 v119, s58, v119
    v_mul_f32 v76, v70, v112
    v_mul_f32 v77, v70, v113
    v_mul_f32 v78, v70, v114
    v_mul_f32 v79, v70, v115
    v_fmac_f32 v76, v71, v116
    v_fmac_f32 v77, v71, v117
    v_fmac_f32 v78, v71, v118
    v_fmac_f32 v79, v71, v119
    s_branch L_ook
L_ok1:
    v_and_b32 v120, s58, v120
    v_and_b32 v121, s58, v121
    v_and_b32 v122, s58, v122
    v_and_b32 v123, s58, v123
    v_and_b32 v124, s58, v124
    v_and_b32 v125, s58, v125
    v_and_b32 v126, s58, v126
    v_and_b32 v127, s58, v127
    v_mul_f32 v76, v70, v120
    v_mul_f32 v77, v70, v121
    v_mul_f32 v78, v70, v122
    v_mul_f32 v79, v70, v123
    v_fmac_f32 v76, v71, v124
    v_fmac_f32 v77, v71, v125
    v_fmac_f32 v78, v71, v126
    v_fmac_f32 v79, v71, v127
    s_branch L_ook
L_ok2:
    v_and_b32 v128, s58, v128
    v_and_b32 v129, s58, v129
    v_and_b32 v130, s58, v130
    v_and_b32 v131, s58, v131
    v_and_b32 v132, s58, v132
    v_and_b32 v133, s58, v133
    v_and_b32 v134, s58, v134
    v_and_b32 v135, s58, v135
    v_mul_f32 v76, v70, v128
    v_mul_f32 v77, v70, v129
    v_mul_f32 v78, v70, v130
    v_mul_f32 v79, v70, v131
    v_fmac_f32 v76, v71, v132
    v_fmac_f32 v77, v71, v133
    v_fmac_f32 v78, v71, v134
    v_fmac_f32 v79, v71, v135
L_ook:
    v_add_f32_dpp v76, v76, v76 row_ror:8 row_mask:0xf bank_mask:0xf
    v_add_f32_dpp v77, v77, v77 row_ror:8 row_mask:0xf bank_mask:0xf
    v_add_f32_dpp v78, v78, v78 row_ror:8 row_mask:0xf bank_mask:0xf
    v_add_f32_dpp v79, v79, v79 row_ror:8 row_mask:0xf bank_mask:0xf
    s_nop 0
    v_permlane32_swap_b32 v76, v77
    v_permlane32_swap_b32 v78, v79
    v_add_f32 v76, v76, v77
    v_add_f32 v78, v78, v79
    s_nop 1
    v_permlane16_swap_b32 v76, v78
    v_add_f32 v76, v76, v78
    v_mul_f32 v76, v76, v72
    v_cvt_pk_bf16_f32 v76, v76, v76
    s_mov_b32 exec_lo, 0x00ff00ff
    s_mov_b32 exec_hi, 0x00ff00ff
    global_store_short v245, v76, s[16:17]
    s_cmp_eq_u32 s23, 15
    s_cbranch_scc0 L_now
    s_mov_b64 exec, 1
    buffer_store_dword v251, off, s[32:35], s60
L_now:
    s_mov_b64 exec, -1
L_end:
    s_endpgm
.section .rodata,"a"
.p2align 6
.amdhsa_kernel standalone__tree_speculative_verify_tree_attention_over_candidate_token_tree__decode_kernel
  .amdhsa_next_free_vgpr 256
  .amdhsa_next_free_sgpr 100
  .amdhsa_accum_offset 256
  .amdhsa_group_segment_fixed_size 0
  .amdhsa_kernarg_size 72
  .amdhsa_user_sgpr_count 2
  .amdhsa_user_sgpr_kernarg_segment_ptr 1
  .amdhsa_system_sgpr_workgroup_id_x 1
  .amdhsa_float_denorm_mode_32 3
.end_amdhsa_kernel
```
